```python
import torch

def _softmax(x, axis=-1):
    return torch.softmax(x, dim=axis)
def _gelu(x):
    return torch.nn.functional.gelu(x, approximate="tanh")
def _silu(x):
    return torch.nn.functional.silu(x)
def _sigmoid(x):
    return torch.sigmoid(x)
def _layernorm(x, axis=-1, eps=1e-5):
    m = x.mean(dim=axis, keepdim=True)
    v = x.var(dim=axis, keepdim=True, unbiased=False)
    return (x - m) / torch.sqrt(v + eps)
def _scatter_add(tgt, idx, src, axis=0):
    return tgt.clone().index_add_(axis, idx, src)
def _segment_sum(src, seg, n):
    out = torch.zeros((n,) + src.shape[1:], dtype=src.dtype)
    return out.index_add_(0, seg, src)
def _pad(x, pw):
    flat = tuple(v for pair in reversed(pw) for v in pair)
    return torch.nn.functional.pad(x, flat)

kernel_name = 'gather_scatter__cheap_equivariant_egnn__graph'

def setup_inputs():

    _w = (lambda a: (lambda t: t.to(torch.bfloat16) if t.is_floating_point() else t)(torch.as_tensor(a)))
    N, deg, D, De = 10000, 64, 64, max(0, 1)
    E = N * deg
    return {
        "h": _w((lambda *s: torch.randn(*s, dtype=torch.bfloat16) * 0.1)(N, D)),
        "pos": _w((lambda *s: torch.randn(*s, dtype=torch.bfloat16) * 0.8)(N, 3)),
        "e_attr": _w((lambda *s: torch.randn(*s, dtype=torch.bfloat16) * 0.8)(E, De)),
        "src": _w((lambda lo, hi, *s: torch.randint(lo, hi, s))(0, N, E).to(torch.int64)),
        "dst": _w((lambda lo, hi, *s: torch.randint(lo, hi, s))(0, N, E).to(torch.int64)),
        "w_e": _w(0.1 * (lambda *s: torch.randn(*s, dtype=torch.bfloat16) * 0.8)(2 * D + 1 + De, D)),
        "w_x": _w(0.1 * (lambda *s: torch.randn(*s, dtype=torch.bfloat16) * 0.1)(D, 1)),
        "w_h": _w(0.1 * (lambda *s: torch.randn(*s, dtype=torch.bfloat16) * 0.1)(2 * D, D)),
    }

def reference(h, pos, e_attr, src, dst, w_e, w_x, w_h):
    N, D = h.shape[0], h.shape[1]
    diff = pos[dst] - pos[src]
    dist2 = torch.sum(diff * diff, axis=-1, keepdims=True)
    e_in = torch.concatenate([h[dst], h[src], dist2, e_attr], axis=-1)
    m_ij = _silu(e_in @ w_e)
    coord_scale = m_ij @ w_x
    pos_new = pos + _segment_sum(diff * coord_scale, dst, N)
    m_i = _segment_sum(m_ij, dst, N)
    h_new = h + _silu(torch.concatenate([h, m_i], axis=-1) @ w_h)
    return h_new, pos_new
```

```asm
; @launch grid=(250,1,1) block=(512,1,1) lds=163840
.amdgcn_target "amdgcn-amd-amdhsa--gfx950"
.text
.globl gather_scatter__cheap_equivariant_egnn__graph_kernel
.p2align 8
.type gather_scatter__cheap_equivariant_egnn__graph_kernel,@function
gather_scatter__cheap_equivariant_egnn__graph_kernel:
    s_cmp_ge_u32 s2, 250
    s_cbranch_scc1 L_k2_end
    s_load_dwordx16 s[16:31], s[0:1], 0
    s_load_dwordx4 s[32:35], s[0:1], 64
    s_load_dwordx2 s[68:69], s[0:1], 80
    s_mov_b32 s70, s2
    s_and_b32 s3, s2, 7
    s_lshr_b32 s51, s2, 3
    s_min_u32 s78, s3, 2
    s_mul_i32 s3, s3, 31
    s_add_u32 s2, s51, s3
    s_add_u32 s2, s2, s78
    v_and_b32 v1, 63, v0
    v_lshrrev_b32 v16, 6, v0
    v_lshlrev_b32 v18, 2, v0
    v_mov_b32 v15, 0
    v_readfirstlane_b32 s76, v16
    v_cmp_gt_u32 vcc, 256, v0
    s_nop 0
    s_mov_b64 exec, vcc
    ds_write_b32 v18, v15 offset:0
    s_mov_b64 exec, -1
    s_mul_i32 s77, s70, 10240
    s_mul_i32 s78, s70, 5120
    v_lshl_add_u32 v20, v0, 4, s77
    s_add_u32 s77, s77, 8192
    v_add_u32 v21, s77, v18
    v_lshl_add_u32 v22, v0, 3, s78
    s_add_u32 s78, s78, 4096
    v_lshl_add_u32 v23, v0, 1, s78
    v_lshlrev_b32 v17, 4, v1
    v_mov_b32 v30, 1
    s_mov_b32 s38, 7340032
    s_mov_b32 s39, 0x20000
    s_waitcnt lgkmcnt(0)
    global_load_dwordx4 v[108:111], v20, s[24:25]
    global_load_dword v112, v21, s[24:25]
    s_mov_b32 s36, s68
    s_mov_b32 s37, s69
    s_mov_b32 s72, s34
    s_mov_b32 s73, s35
    s_mov_b32 s74, 256
    s_mov_b32 s75, 0x20000
    s_mov_b32 s34, s32
    s_mov_b32 s35, s33
    s_mov_b32 s32, s68
    s_mov_b32 s33, s69
    s_mov_b32 s40, s16
    s_mov_b32 s41, s17
    s_mov_b32 s42, 1280000
    s_mov_b32 s43, 0x20000
    s_mov_b32 s44, s18
    s_mov_b32 s45, s19
    s_mov_b32 s46, 60000
    s_mov_b32 s47, 0x20000
    s_barrier
    global_load_dwordx4 v[100:103], v20, s[22:23]
    global_load_dword v104, v21, s[22:23]
    global_load_dwordx2 v[114:115], v22, s[20:21]
    global_load_ushort v116, v23, s[20:21]
    s_cmp_lt_u32 s76, 5
    s_cbranch_scc1 L_f_tdone
L_f_t5:
    v_lshl_add_u32 v19, s51, 4, v1
    v_lshlrev_b32 v19, 7, v19
    s_cmp_eq_u32 s76, 5
    s_cbranch_scc0 L_f_t6
    s_mov_b32 exec_lo, 0xffff
    s_mov_b32 exec_hi, 0
    buffer_load_dword v215, v19, s[44:47], 0 offen
    s_mov_b64 exec, -1
    s_branch L_f_tdone
L_f_t6:
    s_mul_i32 s78, s51, 5
    v_add_u32 v19, s78, v1
    v_lshlrev_b32 v19, 7, v19
    s_mov_b32 exec_lo, 0x1f
    s_mov_b32 exec_hi, 0
    s_cmp_eq_u32 s76, 6
    s_cbranch_scc0 L_f_t7
    v_min_u32 v19, 16512, v19
    global_load_dword v215, v19, s[26:27]
    s_mov_b64 exec, -1
    s_branch L_f_tdone
L_f_t7:
    v_min_u32 v19, 16256, v19
    global_load_dword v215, v19, s[30:31]
    s_mov_b64 exec, -1
L_f_tdone:
    v_and_b32 v24, 31, v1
    v_lshrrev_b32 v25, 5, v1
    v_and_b32 v26, 0x13, v24
    v_and_b32 v27, 4, v24
    v_lshl_or_b32 v26, v27, 1, v26
    v_and_b32 v27, 8, v24
    v_lshrrev_b32 v27, 1, v27
    v_or_b32 v26, v26, v27
    v_mul_u32_u24 v10, 160, v25
    v_lshl_add_u32 v10, v26, 1, v10
    v_mul_u32_u24 v11, 80, v24
    v_lshl_add_u32 v11, v25, 4, v11
    v_lshlrev_b32 v12, 4, v26
    v_lshrrev_b32 v27, 3, v1
    v_lshlrev_b32 v13, 6, v27
    v_add_u32 v13, 8, v13
    v_and_b32 v28, 7, v1
    v_lshrrev_b32 v29, 2, v27
    v_xor_b32 v28, v28, v29
    v_lshlrev_b32 v28, 4, v28
    v_add_u32 v6, 3072, v28
    v_xor_b32 v7, 32, v28
    v_add_u32 v7, 2048, v7
    v_xor_b32 v8, 64, v28
    v_add_u32 v8, 1024, v8
    v_xor_b32 v9, 96, v28
    v_and_b32 v27, 3, v26
    v_lshlrev_b32 v27, 3, v27
    v_lshrrev_b32 v28, 2, v26
    v_add_u32 v27, v27, v28
    v_lshrrev_b32 v28, 2, v27
    v_xor_b32 v28, v28, v25
    v_lshlrev_b32 v28, 4, v28
    v_lshlrev_b32 v27, 7, v27
    v_add_u32 v2, v27, v28
    v_xor_b32 v29, 32, v28
    v_add_u32 v3, v27, v29
    v_xor_b32 v29, 64, v28
    v_add_u32 v4, v27, v29
    v_xor_b32 v29, 96, v28
    v_add_u32 v5, v27, v29
    v_and_b32 v27, 15, v1
    v_lshrrev_b32 v28, 4, v1
    v_lshlrev_b32 v200, 7, v27
    v_lshl_add_u32 v201, v28, 3, v200
    v_lshl_add_u32 v200, v28, 4, v200
    v_and_b32 v202, 7, v1
    v_lshlrev_b32 v202, 2, v202
    v_lshrrev_b32 v29, 2, v27
    v_lshl_add_u32 v199, v28, 3, v29
    v_lshlrev_b32 v199, 7, v199
    v_and_b32 v27, 3, v27
    v_lshl_add_u32 v199, v27, 3, v199
    v_lshrrev_b32 v32, 1, v28
    v_lshl_add_u32 v32, v32, 3, v29
    v_lshlrev_b32 v32, 7, v32
    v_and_b32 v28, 1, v28
    v_lshl_add_u32 v32, v28, 5, v32
    v_lshl_add_u32 v32, v27, 3, v32
    v_lshrrev_b32 v27, 3, v24
    v_and_b32 v28, 3, v24
    v_lshl_add_u32 v27, v27, 2, v28
    v_lshlrev_b32 v27, 7, v27
    v_lshl_add_u32 v33, v25, 4, v27
    v_lshlrev_b32 v197, 7, v25
    v_lshl_add_u32 v197, v24, 1, v197
    v_lshlrev_b32 v198, 4, v25
    v_lshrrev_b32 v27, 2, v24
    v_and_b32 v28, 1, v27
    v_lshlrev_b32 v28, 4, v28
    v_mov_b32 v29, 0x3f80
    v_lshlrev_b32 v29, v28, v29
    v_lshrrev_b32 v27, 1, v27
    v_and_b32 v28, 3, v1
    v_cmp_eq_u32 vcc, v27, v28
    s_nop 1
    v_cndmask_b32 v203, 0, v29, vcc
    s_mov_b32 s84, 0x05040100
    s_mov_b32 s85, 0x05040302
    s_cmp_lt_u32 s76, 4
    s_cbranch_scc1 L_f_d4
    s_cmp_eq_u32 s76, 4
    s_cbranch_scc1 L_f_d7
    s_waitcnt vmcnt(5)
    s_branch L_f_dd
L_f_d7:
    s_waitcnt vmcnt(4)
    s_branch L_f_dd
L_f_d4:
    s_waitcnt vmcnt(4)
L_f_dd:
    v_mul_u32_u24 v142, 52429, v108
    v_lshrrev_b32 v137, 19, v142
    v_lshrrev_b32 v142, 18, v142
    v_and_b32 v137, -4, v137
    ds_add_rtn_u32 v132, v137, v30 offset:0
    v_mad_i32_i24 v147, v142, -5, v108
    v_and_b32 v142, 7, v142
    v_lshl_add_u32 v142, v142, 3, v147
    v_mul_u32_u24 v143, 52429, v109
    v_lshrrev_b32 v138, 19, v143
    v_lshrrev_b32 v143, 18, v143
    v_and_b32 v138, -4, v138
    ds_add_rtn_u32 v133, v138, v30 offset:0
    v_mad_i32_i24 v147, v143, -5, v109
    v_and_b32 v143, 7, v143
    v_lshl_add_u32 v143, v143, 3, v147
    v_mul_u32_u24 v144, 52429, v110
    v_lshrrev_b32 v139, 19, v144
    v_lshrrev_b32 v144, 18, v144
    v_and_b32 v139, -4, v139
    ds_add_rtn_u32 v134, v139, v30 offset:0
    v_mad_i32_i24 v147, v144, -5, v110
    v_and_b32 v144, 7, v144
    v_lshl_add_u32 v144, v144, 3, v147
    v_mul_u32_u24 v145, 52429, v111
    v_lshrrev_b32 v140, 19, v145
    v_lshrrev_b32 v145, 18, v145
    v_and_b32 v140, -4, v140
    ds_add_rtn_u32 v135, v140, v30 offset:0
    v_mad_i32_i24 v147, v145, -5, v111
    v_and_b32 v145, 7, v145
    v_lshl_add_u32 v145, v145, 3, v147
    v_mul_u32_u24 v146, 52429, v112
    v_lshrrev_b32 v141, 19, v146
    v_lshrrev_b32 v146, 18, v146
    v_and_b32 v141, -4, v141
    ds_add_rtn_u32 v136, v141, v30 offset:0
    v_mad_i32_i24 v147, v146, -5, v112
    v_and_b32 v146, 7, v146
    v_lshl_add_u32 v146, v146, 3, v147
    s_lshl_b32 s77, s76, 11
    v_add_u32 v19, s77, v17
    s_add_u32 m0, s77, 147456
    s_lshl_b32 s77, s76, 10
    global_load_lds_dwordx4 v19, s[26:27]
    global_load_lds_dwordx4 v19, s[26:27] offset:1024
    s_cmp_lt_u32 s76, 5
    s_cbranch_scc0 L_f_l5
    s_mul_i32 s79, s2, 5120
    s_add_u32 m0, s77, 108544
    s_add_u32 s79, s79, s77
    buffer_load_dwordx4 v17, s[40:43], s79 offen lds
    s_branch L_f_ldone
L_f_l5:
    s_cmp_eq_u32 s76, 7
    s_cbranch_scc0 L_f_ldone
    s_mov_b32 m0, 142336
    v_add_u32 v19, 16384, v17
    s_mov_b32 exec_lo, 0xffff
    s_mov_b32 exec_hi, 0
    global_load_lds_dwordx4 v19, s[26:27]
    s_mov_b32 m0, 142592
    s_mov_b32 exec_lo, 0xff
    s_nop 0
    global_load_lds_dwordx4 v17, s[28:29]
    s_mov_b64 exec, -1
L_f_ldone:
    v_lshlrev_b32 v19, 1, v0
    s_mul_i32 s78, s2, 240
    v_add_u32 v19, s78, v19
    v_min_u32 v19, 59998, v19
    global_load_ushort v208, v19, s[18:19]
    s_cmp_lg_u32 s76, 0
    s_cbranch_scc1 L_f_noplld
    s_mul_i32 s78, s2, 40
    v_add_u32 v19, s78, v1
    v_min_u32 v19, 9999, v19
    v_mul_u32_u24 v19, 6, v19
    global_load_ushort v170, v19, s[18:19]
    global_load_ushort v171, v19, s[18:19] offset:2
    global_load_ushort v172, v19, s[18:19] offset:4
L_f_noplld:
    s_waitcnt lgkmcnt(0)
    s_barrier
    ds_read_b128 v[152:155], v17 offset:0
    s_waitcnt lgkmcnt(0)
    v_add_u32 v156, v152, v153
    v_add_u32 v157, v156, v154
    v_add_u32 v158, v157, v155
    v_mov_b32 v159, v158
    s_nop 1
    v_add_u32_dpp v159, v159, v159 row_shr:1 row_mask:0xf bank_mask:0xf bound_ctrl:0
    s_nop 1
    v_add_u32_dpp v159, v159, v159 row_shr:2 row_mask:0xf bank_mask:0xf bound_ctrl:0
    s_nop 1
    v_add_u32_dpp v159, v159, v159 row_shr:4 row_mask:0xf bank_mask:0xf bound_ctrl:0
    s_nop 1
    v_add_u32_dpp v159, v159, v159 row_shr:8 row_mask:0xf bank_mask:0xf bound_ctrl:0
    s_nop 1
    v_add_u32_dpp v159, v159, v159 row_bcast:15 row_mask:0xa bank_mask:0xf
    s_nop 1
    v_add_u32_dpp v159, v159, v159 row_bcast:31 row_mask:0xc bank_mask:0xf
    v_sub_u32 v160, v159, v158
    v_add_u32 v161, v160, v152
    v_add_u32 v162, v160, v156
    v_add_u32 v163, v160, v157
    ds_write_b128 v17, v[160:163] offset:1024
    ds_read_b32 v176, v137 offset:1024
    ds_read_b32 v177, v138 offset:1024
    ds_read_b32 v178, v139 offset:1024
    ds_read_b32 v179, v140 offset:1024
    ds_read_b32 v180, v141 offset:1024
    s_cmp_eq_u32 s76, 0
    s_cbranch_scc1 L_f_e7
    s_cmp_eq_u32 s76, 7
    s_cbranch_scc1 L_f_e6
    s_waitcnt vmcnt(4)
    s_branch L_f_ed
L_f_e6:
    s_waitcnt vmcnt(6)
    s_branch L_f_ed
L_f_e7:
    s_waitcnt vmcnt(7)
L_f_ed:
    v_lshl_or_b32 v120, v142, 16, v100
    v_perm_b32 v121, v108, v114, s84
    v_lshl_or_b32 v122, v143, 16, v101
    v_perm_b32 v123, v109, v114, s85
    v_lshl_or_b32 v124, v144, 16, v102
    v_perm_b32 v125, v110, v115, s84
    v_lshl_or_b32 v126, v145, 16, v103
    v_perm_b32 v127, v111, v115, s85
    v_lshl_or_b32 v128, v146, 16, v104
    v_perm_b32 v129, v112, v116, s84
    s_mov_b32 s71, 88064
    s_cmp_lg_u32 s76, 0
    s_cbranch_scc1 L_k1_noseg
    v_lshl_or_b32 v156, v152, 16, v160
    v_lshl_or_b32 v157, v153, 16, v161
    v_lshl_or_b32 v158, v154, 16, v162
    v_lshl_or_b32 v159, v155, 16, v163
    s_lshl_b32 s79, s70, 10
    s_add_u32 s79, s79, 5242880
    buffer_store_dwordx4 v[156:159], v17, s[36:39], s79 offen sc1
L_k1_noseg:
    s_waitcnt lgkmcnt(4)
    v_add_u32 v176, v176, v132
    v_lshl_add_u32 v176, v176, 3, s71
    ds_write_b64 v176, v[120:121]
    s_waitcnt lgkmcnt(4)
    v_add_u32 v177, v177, v133
    v_lshl_add_u32 v177, v177, 3, s71
    ds_write_b64 v177, v[122:123]
    s_waitcnt lgkmcnt(4)
    v_add_u32 v178, v178, v134
    v_lshl_add_u32 v178, v178, 3, s71
    ds_write_b64 v178, v[124:125]
    s_waitcnt lgkmcnt(4)
    v_add_u32 v179, v179, v135
    v_lshl_add_u32 v179, v179, 3, s71
    ds_write_b64 v179, v[126:127]
    s_waitcnt lgkmcnt(4)
    v_add_u32 v180, v180, v136
    v_lshl_add_u32 v180, v180, 3, s71
    ds_write_b64 v180, v[128:129]
    v_lshlrev_b32 v20, 4, v0
    v_add_u32 v21, s71, v20
    s_mul_i32 s79, s70, 20480
    s_add_u32 s78, s79, 8192
    s_add_u32 s77, s79, 16384
    s_waitcnt lgkmcnt(0)
    s_barrier
    ds_read_b128 v[120:123], v21
    ds_read_b128 v[124:127], v21 offset:8192
    s_cmp_lt_u32 s76, 4
    s_cbranch_scc0 L_k1_c2
    ds_read_b128 v[128:131], v21 offset:16384
    s_waitcnt lgkmcnt(0)
    buffer_store_dwordx4 v[128:131], v20, s[36:39], s77 offen sc1
L_k1_c2:
    s_waitcnt lgkmcnt(0)
    buffer_store_dwordx4 v[120:123], v20, s[36:39], s79 offen sc1
    buffer_store_dwordx4 v[124:127], v20, s[36:39], s78 offen sc1
    s_cmp_ge_u32 s76, 4
    s_cbranch_scc1 L_f_o2
    s_cmp_eq_u32 s76, 0
    s_cbranch_scc1 L_f_o4
    s_waitcnt vmcnt(3)
    s_branch L_f_od
L_f_o4:
    s_waitcnt vmcnt(4)
    s_branch L_f_od
L_f_o2:
    s_waitcnt vmcnt(2)
L_f_od:
    s_cmp_lg_u32 s76, 0
    s_cbranch_scc1 L_f_nopl
    v_lshl_or_b32 v170, v171, 16, v170
    v_mov_b32 v171, v172
    v_lshlrev_b32 v172, 3, v1
    s_mov_b32 exec_hi, 0xff
    ds_write_b64 v172, v[170:171] offset:21248
    s_mov_b64 exec, -1
L_f_nopl:
    s_waitcnt lgkmcnt(0)
    v_mov_b32 v84, 0
    v_mov_b32 v85, 0
    v_mov_b32 v86, 0
    v_mov_b32 v87, 0
    s_mul_i32 s79, s76, 2560
    v_add_u32 v18, s79, v17
    ds_write_b128 v18, v[84:87] offset:0
    ds_write_b128 v18, v[84:87] offset:1024
    v_lshlrev_b32 v91, 2, v1
    ds_write_b32 v91, v15 offset:20480
    s_mov_b32 exec_hi, 0
    ds_write_b128 v18, v[84:87] offset:2048
    ds_write_b32 v91, v203 offset:20992
    s_mov_b64 exec, -1
    s_mov_b32 s80, 0
    s_mov_b32 s81, -1
    s_mov_b32 s58, 0xffff0000
    v_lshlrev_b32 v18, 5, v0
    v_add_u32 v18, 147456, v18
    ds_read_b128 v[68:71], v18
    ds_read_b128 v[72:75], v18 offset:16
    s_mov_b32 s77, 3216550459
    s_waitcnt lgkmcnt(0)
    v_lshlrev_b32 v217, 4, v1
    s_lshl_b32 s79, s76, 13
    s_add_u32 s71, s79, 0
    s_add_u32 m0, s79, 22528
    s_nop 0
    buffer_load_dwordx4 v217, s[44:47], s71 offen offset:0 lds
    v_lshlrev_b32 v84, 16, v68
    v_and_b32 v85, s58, v68
    v_mul_f32 v84, s77, v84
    v_mul_f32 v85, s77, v85
    v_cvt_pk_bf16_f32 v68, v84, v85
    v_lshlrev_b32 v84, 16, v69
    v_and_b32 v85, s58, v69
    v_mul_f32 v84, s77, v84
    v_mul_f32 v85, s77, v85
    v_cvt_pk_bf16_f32 v69, v84, v85
    buffer_load_dwordx4 v217, s[44:47], s71 offen offset:1024 lds
    v_lshlrev_b32 v84, 16, v70
    v_and_b32 v85, s58, v70
    v_mul_f32 v84, s77, v84
    v_mul_f32 v85, s77, v85
    v_cvt_pk_bf16_f32 v70, v84, v85
    v_lshlrev_b32 v84, 16, v71
    v_and_b32 v85, s58, v71
    v_mul_f32 v84, s77, v84
    v_mul_f32 v85, s77, v85
    v_cvt_pk_bf16_f32 v71, v84, v85
    buffer_load_dwordx4 v217, s[44:47], s71 offen offset:2048 lds
    v_lshlrev_b32 v84, 16, v72
    v_and_b32 v85, s58, v72
    v_mul_f32 v84, s77, v84
    v_mul_f32 v85, s77, v85
    v_cvt_pk_bf16_f32 v72, v84, v85
    v_lshlrev_b32 v84, 16, v73
    v_and_b32 v85, s58, v73
    v_mul_f32 v84, s77, v84
    v_mul_f32 v85, s77, v85
    v_cvt_pk_bf16_f32 v73, v84, v85
    buffer_load_dwordx4 v217, s[44:47], s71 offen offset:3072 lds
    v_lshlrev_b32 v84, 16, v74
    v_and_b32 v85, s58, v74
    v_mul_f32 v84, s77, v84
    v_mul_f32 v85, s77, v85
    v_cvt_pk_bf16_f32 v74, v84, v85
    v_lshlrev_b32 v84, 16, v75
    v_and_b32 v85, s58, v75
    v_mul_f32 v84, s77, v84
    v_mul_f32 v85, s77, v85
    v_cvt_pk_bf16_f32 v75, v84, v85
    ds_write_b128 v18, v[68:71]
    ds_write_b128 v18, v[72:75] offset:16
    s_cmp_lg_u32 s76, 7
    s_cbranch_scc1 L_f_noxw
    v_and_b32 v19, 31, v1
    v_lshlrev_b32 v19, 1, v19
    v_add_u32 v19, 142336, v19
    ds_read_u16 v164, v19
    ds_read_u16 v165, v19 offset:128
    ds_read_u16 v166, v19 offset:64
    ds_read_u16 v167, v19 offset:192
    ds_read_u16 v168, v19 offset:256
    ds_read_u16 v169, v19 offset:320
    s_waitcnt lgkmcnt(0)
    v_lshlrev_b32 v164, 16, v164
    v_lshlrev_b32 v165, 16, v165
    v_mul_f32 v164, s77, v164
    v_mul_f32 v165, s77, v165
    v_cvt_pk_bf16_f32 v64, v164, v165
    v_lshlrev_b32 v65, 16, v64
    v_and_b32 v66, s58, v64
    v_sub_f32 v65, v164, v65
    v_sub_f32 v66, v165, v66
    v_cvt_pk_bf16_f32 v65, v65, v66
    v_cndmask_b32 v174, v64, v65, s[80:81]
    v_lshlrev_b32 v166, 16, v166
    v_lshlrev_b32 v167, 16, v167
    v_mul_f32 v166, s77, v166
    v_mul_f32 v167, s77, v167
    v_cvt_pk_bf16_f32 v64, v166, v167
    v_lshlrev_b32 v65, 16, v64
    v_and_b32 v66, s58, v64
    v_sub_f32 v65, v166, v65
    v_sub_f32 v66, v167, v66
    v_cvt_pk_bf16_f32 v65, v65, v66
    v_cndmask_b32 v175, v64, v65, s[80:81]
    s_mov_b32 s78, 3207688728
    v_lshlrev_b32 v168, 16, v168
    v_lshlrev_b32 v169, 16, v169
    v_mul_f32 v172, s78, v168
    v_mul_f32 v173, s78, v169
    v_lshlrev_b32 v19, 4, v1
    v_add_u32 v19, 142848, v19
    ds_write_b128 v19, v[172:175]
L_f_noxw:
    s_waitcnt vmcnt(4) lgkmcnt(0)
    s_barrier
    s_cmp_lg_u32 s76, 0
    s_cbranch_scc1 L_f_nosig
    s_and_b32 s77, s70, 15
    s_lshl_b32 s77, s77, 4
    v_mov_b32 v18, s77
    s_mov_b64 exec, 1
    buffer_atomic_add v30, v18, s[72:75], 0 offen sc1
    s_mov_b64 exec, -1
L_f_nosig:
    s_lshl_b32 s77, s76, 11
    v_add_u32 v19, s77, v17
    s_add_u32 m0, s77, 118784
    s_nop 0
    global_load_lds_dwordx4 v19, s[30:31]
    global_load_lds_dwordx4 v19, s[30:31] offset:1024
    v_lshlrev_b32 v19, 4, v1
    v_add_u32 v19, 142848, v19
    ds_read_b128 v[204:207], v19
    v_add_u32 v19, 147456, v32
    s_mul_i32 s77, s76, 640
    s_add_u32 s77, s77, 108544
    v_add_u32 v17, s77, v33
    ds_read_b128 v[44:47], v17 offset:0
    ds_read_b128 v[48:51], v17 offset:32
    ds_read_b128 v[52:55], v17 offset:64
    ds_read_b128 v[56:59], v17 offset:96
    s_lshl_b32 s79, s76, 13
    s_add_u32 s71, s79, 4096
    s_add_u32 m0, s79, 26624
    s_nop 0
    buffer_load_dwordx4 v217, s[44:47], s71 offen offset:0 lds
    ds_read_b64_tr_b16 v[68:69], v19 offset:0
    ds_read_b64_tr_b16 v[70:71], v19 offset:512
    ds_read_b64_tr_b16 v[84:85], v19 offset:64
    ds_read_b64_tr_b16 v[86:87], v19 offset:576
    buffer_load_dwordx4 v217, s[44:47], s71 offen offset:1024 lds
    ds_read_b64_tr_b16 v[72:73], v19 offset:2048
    ds_read_b64_tr_b16 v[74:75], v19 offset:2560
    ds_read_b64_tr_b16 v[88:89], v19 offset:2112
    ds_read_b64_tr_b16 v[90:91], v19 offset:2624
    buffer_load_dwordx4 v217, s[44:47], s71 offen offset:2048 lds
    ds_read_b64_tr_b16 v[76:77], v19 offset:4096
    ds_read_b64_tr_b16 v[78:79], v19 offset:4608
    ds_read_b64_tr_b16 v[92:93], v19 offset:4160
    ds_read_b64_tr_b16 v[94:95], v19 offset:4672
    buffer_load_dwordx4 v217, s[44:47], s71 offen offset:3072 lds
    ds_read_b64_tr_b16 v[80:81], v19 offset:6144
    ds_read_b64_tr_b16 v[82:83], v19 offset:6656
    ds_read_b64_tr_b16 v[96:97], v19 offset:6208
    ds_read_b64_tr_b16 v[98:99], v19 offset:6720
    s_mul_i32 s78, s51, 313
    s_lshl_b32 s79, s76, 6
    s_add_u32 s78, s78, s79
    v_add_u32 v218, s78, v1
    v_lshlrev_b32 v218, 7, v218
    s_cmp_lt_u32 s76, 5
    s_cselect_b32 s78, 0, 0x4000000
    buffer_load_dword v216, v218, s[40:43], s78 offen
    s_waitcnt lgkmcnt(0)
    v_mfma_f32_32x32x16_bf16 v[100:115], v[44:47], v[68:71], 0
    ds_read_b64_tr_b16 v[164:165], v19 offset:8192
    ds_read_b64_tr_b16 v[166:167], v19 offset:8704
    v_mfma_f32_32x32x16_bf16 v[116:131], v[44:47], v[84:87], 0
    ds_read_b64_tr_b16 v[180:181], v19 offset:8256
    ds_read_b64_tr_b16 v[182:183], v19 offset:8768
    v_mfma_f32_32x32x16_bf16 v[100:115], v[48:51], v[72:75], v[100:115]
    ds_read_b64_tr_b16 v[168:169], v19 offset:10240
    ds_read_b64_tr_b16 v[170:171], v19 offset:10752
    v_mfma_f32_32x32x16_bf16 v[116:131], v[48:51], v[88:91], v[116:131]
    ds_read_b64_tr_b16 v[184:185], v19 offset:10304
    ds_read_b64_tr_b16 v[186:187], v19 offset:10816
    v_mfma_f32_32x32x16_bf16 v[100:115], v[52:55], v[76:79], v[100:115]
    ds_read_b64_tr_b16 v[172:173], v19 offset:12288
    ds_read_b64_tr_b16 v[174:175], v19 offset:12800
    v_mfma_f32_32x32x16_bf16 v[116:131], v[52:55], v[92:95], v[116:131]
    ds_read_b64_tr_b16 v[188:189], v19 offset:12352
    ds_read_b64_tr_b16 v[190:191], v19 offset:12864
    v_mfma_f32_32x32x16_bf16 v[100:115], v[56:59], v[80:83], v[100:115]
    ds_read_b64_tr_b16 v[176:177], v19 offset:14336
    ds_read_b64_tr_b16 v[178:179], v19 offset:14848
    v_mfma_f32_32x32x16_bf16 v[116:131], v[56:59], v[96:99], v[116:131]
    ds_read_b64_tr_b16 v[192:193], v19 offset:14400
    ds_read_b64_tr_b16 v[194:195], v19 offset:14912
    v_mov_b32 v60, 0
    v_mov_b32 v61, 0
    v_mov_b32 v62, 0
    v_mov_b32 v63, 0
    s_mul_i32 s78, s76, 1536
    s_add_u32 s78, s78, 88064
    v_lshl_add_u32 v18, v1, 2, s78
    v_mov_b32 v105, 0
    v_cvt_pk_bf16_f32 v64, v100, v101
    v_lshlrev_b32 v65, 16, v64
    v_and_b32 v66, s58, v64
    v_sub_f32 v65, v100, v65
    v_sub_f32 v66, v101, v66
    v_cvt_pk_bf16_f32 v65, v65, v66
    v_cndmask_b32 v67, v64, v65, s[80:81]
    ds_write_b32 v18, v67 offset:0
    v_cvt_pk_bf16_f32 v64, v102, v103
    v_lshlrev_b32 v65, 16, v64
    v_and_b32 v66, s58, v64
    v_sub_f32 v65, v102, v65
    v_sub_f32 v66, v103, v66
    v_cvt_pk_bf16_f32 v65, v65, v66
    v_cndmask_b32 v67, v64, v65, s[80:81]
    ds_write_b32 v18, v67 offset:256
    v_cvt_pk_bf16_f32 v64, v104, v105
    v_lshlrev_b32 v65, 16, v64
    v_and_b32 v66, s58, v64
    v_sub_f32 v65, v104, v65
    v_sub_f32 v66, v105, v66
    v_cvt_pk_bf16_f32 v65, v65, v66
    v_cndmask_b32 v67, v64, v65, s[80:81]
    ds_write_b32 v18, v67 offset:512
    v_mov_b32 v121, 0
    v_cvt_pk_bf16_f32 v64, v116, v117
    v_lshlrev_b32 v65, 16, v64
    v_and_b32 v66, s58, v64
    v_sub_f32 v65, v116, v65
    v_sub_f32 v66, v117, v66
    v_cvt_pk_bf16_f32 v65, v65, v66
    v_cndmask_b32 v67, v64, v65, s[80:81]
    ds_write_b32 v18, v67 offset:768
    v_cvt_pk_bf16_f32 v64, v118, v119
    v_lshlrev_b32 v65, 16, v64
    v_and_b32 v66, s58, v64
    v_sub_f32 v65, v118, v65
    v_sub_f32 v66, v119, v66
    v_cvt_pk_bf16_f32 v65, v65, v66
    v_cndmask_b32 v67, v64, v65, s[80:81]
    ds_write_b32 v18, v67 offset:1024
    v_cvt_pk_bf16_f32 v64, v120, v121
    v_lshlrev_b32 v65, 16, v64
    v_and_b32 v66, s58, v64
    v_sub_f32 v65, v120, v65
    v_sub_f32 v66, v121, v66
    v_cvt_pk_bf16_f32 v65, v65, v66
    v_cndmask_b32 v67, v64, v65, s[80:81]
    ds_write_b32 v18, v67 offset:1280
    v_mfma_f32_32x32x16_bf16 v[100:115], v[60:63], v[60:63], 0
    v_mfma_f32_32x32x16_bf16 v[116:131], v[60:63], v[60:63], 0
    s_lshl_b32 s57, s76, 12
    s_add_u32 s57, s57, 75776
    v_mov_b32 v14, 0x3f80
    v_add_u32 v2, s57, v2
    v_add_u32 v3, s57, v3
    v_add_u32 v4, s57, v4
    v_add_u32 v5, s57, v5
    v_mov_b32 v212, v12
    v_mov_b32 v213, v13
    v_mov_b32 v214, v11
    v_lshrrev_b32 v19, 1, v0
    v_lshlrev_b32 v31, 10, v19
    s_lshl_b32 s77, s2, 2
    s_add_u32 s77, s77, 5242880
    v_lshrrev_b32 v85, 1, v0
    v_mov_b32 v86, 2560
    v_and_b32 v84, 1, v0
    s_mov_b32 s53, 0
    s_mov_b32 s60, 1
    s_mov_b32 s66, 1
    s_movk_i32 s49, 448
    s_mul_i32 s78, s2, 320
    s_sub_u32 s78, 21248, s78
    v_mov_b32 v215, s78
    s_waitcnt lgkmcnt(0)
    s_cmp_lg_u32 s76, 7
    s_cbranch_scc1 L_f_go
    v_lshlrev_b32 v18, 4, v1
    s_mov_b32 s78, 0
L_f_poll:
    s_mov_b32 exec_lo, 0xffff
    s_mov_b32 exec_hi, 0
    buffer_load_dword v19, v18, s[72:75], 0 offen sc1
    s_waitcnt vmcnt(0)
    v_add_u32_dpp v19, v19, v19 row_shr:1 row_mask:0xf bank_mask:0xf bound_ctrl:0
    s_nop 1
    v_add_u32_dpp v19, v19, v19 row_shr:2 row_mask:0xf bank_mask:0xf bound_ctrl:0
    s_nop 1
    v_add_u32_dpp v19, v19, v19 row_shr:4 row_mask:0xf bank_mask:0xf bound_ctrl:0
    s_nop 1
    v_add_u32_dpp v19, v19, v19 row_shr:8 row_mask:0xf bank_mask:0xf bound_ctrl:0
    s_mov_b64 exec, -1
    v_readlane_b32 s79, v19, 15
    s_add_u32 s78, s78, 1
    s_cmp_ge_u32 s79, 250
    s_cbranch_scc1 L_f_go0
    s_cmp_gt_u32 s78, 400000
    s_cbranch_scc1 L_f_go0
    s_sleep 1
    s_branch L_f_poll
L_f_go0:
    v_lshrrev_b32 v19, 1, v0
L_f_go:
    s_waitcnt vmcnt(1)
    s_barrier
    s_mov_b32 s71, 0
L_f_again:
    v_mov_b32 v98, 0
    v_cmp_gt_u32 vcc, 250, v19
    s_nop 0
    s_mov_b64 exec, vcc
    buffer_load_dword v98, v31, s[36:39], s77 offen sc1
    s_mov_b64 exec, -1
    v_cmp_eq_u32 vcc, 0, v84
    s_waitcnt vmcnt(0)
    v_lshrrev_b32 v209, 16, v98
    v_and_b32 v210, 0xffff, v98
    v_cndmask_b32 v211, 0, v209, vcc
    v_mad_u32_u24 v210, v85, v86, v210
    s_nop 0
    v_add_u32_dpp v211, v211, v211 row_shr:1 row_mask:0xf bank_mask:0xf bound_ctrl:0
    s_nop 1
    v_add_u32_dpp v211, v211, v211 row_shr:2 row_mask:0xf bank_mask:0xf bound_ctrl:0
    s_nop 1
    v_add_u32_dpp v211, v211, v211 row_shr:4 row_mask:0xf bank_mask:0xf bound_ctrl:0
    s_nop 1
    v_add_u32_dpp v211, v211, v211 row_shr:8 row_mask:0xf bank_mask:0xf bound_ctrl:0
    s_nop 1
    v_add_u32_dpp v211, v211, v211 row_bcast:15 row_mask:0xa bank_mask:0xf
    s_nop 1
    v_add_u32_dpp v211, v211, v211 row_bcast:31 row_mask:0xc bank_mask:0xf
    v_lshlrev_b32 v210, 3, v210
    s_lshl_b32 s78, s76, 2
    v_mov_b32 v85, s78
    v_readlane_b32 s48, v211, 63
    s_mov_b32 exec_lo, 0
    s_mov_b32 exec_hi, 0x80000000
    ds_write_b32 v85, v211 offset:20736
    s_mov_b64 exec, -1
    v_sub_u32 v211, v211, v209
L_k2_batch:
    v_sub_u32 v84, s53, v211
    v_max_i32 v85, 0, v84
    v_add_u32 v86, s49, v84
    v_min_i32 v86, v86, v209
    v_and_b32 v87, 1, v0
    v_add_u32 v85, v85, v87
    v_lshl_add_u32 v89, v85, 3, v210
    v_sub_u32 v88, v85, v84
    v_sub_u32 v86, v86, v84
    s_lshl_b32 s79, s76, 11
    s_add_u32 s79, s79, 147456
    v_lshl_add_u32 v88, v88, 2, s79
    v_lshl_add_u32 v86, v86, 2, s79
L_k2_map:
    v_cmp_lt_i32 vcc, v88, v86
    s_nop 0
    s_and_b64 exec, exec, vcc
    s_cbranch_scc0 L_k2_mapdone
    ds_write_b32 v88, v89
    v_add_u32 v88, 8, v88
    v_add_u32 v89, 16, v89
    s_branch L_k2_map
L_k2_mapdone:
    s_mov_b64 exec, -1
    s_sub_i32 s67, s48, s53
    s_min_i32 s67, s67, s49
    v_lshl_add_u32 v16, v1, 2, s79
    v_sub_u32 v18, s67, v1
    ds_read_b32 v84, v16 offset:0
    ds_read_b32 v85, v16 offset:256
    ds_read_b32 v86, v16 offset:512
    ds_read_b32 v87, v16 offset:768
    ds_read_b32 v88, v16 offset:1024
    ds_read_b32 v89, v16 offset:1280
    ds_read_b32 v90, v16 offset:1536
    v_cmp_lt_i32 s[84:85], 0, v18
    v_cmp_lt_i32 s[86:87], 64, v18
    v_cmp_lt_i32 vcc, 128, v18
    s_nop 0
    s_mov_b64 s[88:89], vcc
    v_cmp_lt_i32 vcc, 192, v18
    s_nop 0
    s_mov_b64 s[90:91], vcc
    v_cmp_lt_i32 vcc, 256, v18
    s_nop 0
    s_mov_b64 s[92:93], vcc
    v_cmp_lt_i32 vcc, 320, v18
    s_nop 0
    s_mov_b64 s[94:95], vcc
    v_cmp_lt_i32 vcc, 384, v18
    s_nop 0
    s_mov_b64 s[96:97], vcc
    s_waitcnt lgkmcnt(6)
    s_mov_b64 exec, s[84:85]
    buffer_load_dwordx2 v[134:135], v84, s[36:39], 0 offen sc1
    s_waitcnt lgkmcnt(5)
    s_mov_b64 exec, s[86:87]
    buffer_load_dwordx2 v[138:139], v85, s[36:39], 0 offen sc1
    s_waitcnt lgkmcnt(4)
    s_mov_b64 exec, s[88:89]
    buffer_load_dwordx2 v[142:143], v86, s[36:39], 0 offen sc1
    s_waitcnt lgkmcnt(3)
    s_mov_b64 exec, s[90:91]
    buffer_load_dwordx2 v[146:147], v87, s[36:39], 0 offen sc1
    s_waitcnt lgkmcnt(2)
    s_mov_b64 exec, s[92:93]
    buffer_load_dwordx2 v[150:151], v88, s[36:39], 0 offen sc1
    s_waitcnt lgkmcnt(1)
    s_mov_b64 exec, s[94:95]
    buffer_load_dwordx2 v[154:155], v89, s[36:39], 0 offen sc1
    s_waitcnt lgkmcnt(0)
    s_mov_b64 exec, s[96:97]
    buffer_load_dwordx2 v[158:159], v90, s[36:39], 0 offen sc1
    s_mov_b64 exec, -1
    s_cmp_eq_u32 s60, 0
    s_cbranch_scc0 L_k2_first
    v_lshlrev_b32 v17, 4, v1
    s_lshl_b32 s77, s76, 13
    s_add_u32 s78, s77, 0
    s_add_u32 m0, s77, 22528
    s_nop 0
    buffer_load_dwordx4 v17, s[44:47], s78 offen offset:0 lds
    buffer_load_dwordx4 v17, s[44:47], s78 offen offset:1024 lds
    buffer_load_dwordx4 v17, s[44:47], s78 offen offset:2048 lds
    buffer_load_dwordx4 v17, s[44:47], s78 offen offset:3072 lds
    s_add_u32 s78, s77, 4096
    s_add_u32 m0, s77, 26624
    s_nop 0
    buffer_load_dwordx4 v17, s[44:47], s78 offen offset:0 lds
    buffer_load_dwordx4 v17, s[44:47], s78 offen offset:1024 lds
    buffer_load_dwordx4 v17, s[44:47], s78 offen offset:2048 lds
    buffer_load_dwordx4 v17, s[44:47], s78 offen offset:3072 lds
    s_waitcnt vmcnt(0)
    s_barrier
    s_branch L_k2_go6
L_k2_first:
    v_and_b32 v16, 7, v1
    v_lshlrev_b32 v16, 2, v16
    s_waitcnt lgkmcnt(0)
    s_barrier
    ds_read_b32 v18, v16 offset:20736
    s_mov_b32 s60, 0
    s_waitcnt lgkmcnt(0)
    v_mov_b32 v16, v18
    v_mov_b32 v31, v18
    s_nop 0
    v_add_u32_dpp v16, v16, v16 quad_perm:[1,0,3,2] row_mask:0xf bank_mask:0xf
    v_max_u32_dpp v31, v31, v31 quad_perm:[1,0,3,2] row_mask:0xf bank_mask:0xf
    s_nop 0
    v_add_u32_dpp v16, v16, v16 quad_perm:[2,3,0,1] row_mask:0xf bank_mask:0xf
    v_max_u32_dpp v31, v31, v31 quad_perm:[2,3,0,1] row_mask:0xf bank_mask:0xf
    s_nop 0
    v_add_u32_dpp v16, v16, v16 row_half_mirror row_mask:0xf bank_mask:0xf
    v_max_u32_dpp v31, v31, v31 row_half_mirror row_mask:0xf bank_mask:0xf
    s_nop 0
    v_readfirstlane_b32 s77, v16
    v_readfirstlane_b32 s50, v31
    s_nop 0
    s_min_u32 s50, s50, 640000
    s_cmp_gt_u32 s77, 3072
    s_cselect_b32 s49, 384, s49
    s_cmp_gt_u32 s50, 448
    s_cselect_b32 s49, 384, s49
    s_waitcnt vmcnt(0)
    s_cmp_eq_u32 s49, 448
    s_cbranch_scc0 L_k2_slowfirst
L_k2_go6:
    v_mov_b32 v17, 1
    v_mov_b32 v16, 22528
    s_movk_i32 s77, 0xe0
    s_movk_i32 s64, 320
    v_mad_u32_u16 v18, v134, 6, v16
    v_mad_u32_u16 v19, v135, 8, v215 op_sel:[1,0,0,0]
    v_and_b32 v18, -4, v18
    ds_read_b64 v[58:59], v19
    ds_read2_b32 v[44:45], v18 offset0:0 offset1:1
    v_lshrrev_b32 v91, 14, v134
    v_and_or_b32 v91, v91, s77, v202
    s_mov_b64 exec, s[84:85]
    ds_add_rtn_u32 v84, v91, v17 offset:20480
    s_mov_b64 exec, -1
    v_mad_u32_u16 v18, v138, 6, v16
    v_mad_u32_u16 v19, v139, 8, v215 op_sel:[1,0,0,0]
    v_and_b32 v18, -4, v18
    ds_read_b64 v[60:61], v19
    ds_read2_b32 v[46:47], v18 offset0:0 offset1:1
    v_lshrrev_b32 v92, 14, v138
    v_and_or_b32 v92, v92, s77, v202
    s_mov_b64 exec, s[86:87]
    ds_add_rtn_u32 v85, v92, v17 offset:20480
    s_mov_b64 exec, -1
    v_mad_u32_u16 v18, v142, 6, v16
    v_mad_u32_u16 v19, v143, 8, v215 op_sel:[1,0,0,0]
    v_and_b32 v18, -4, v18
    ds_read_b64 v[62:63], v19
    ds_read2_b32 v[48:49], v18 offset0:0 offset1:1
    v_lshrrev_b32 v93, 14, v142
    v_and_or_b32 v93, v93, s77, v202
    s_mov_b64 exec, s[88:89]
    ds_add_rtn_u32 v86, v93, v17 offset:20480
    s_mov_b64 exec, -1
    v_mad_u32_u16 v18, v146, 6, v16
    v_mad_u32_u16 v19, v147, 8, v215 op_sel:[1,0,0,0]
    v_and_b32 v18, -4, v18
    ds_read_b64 v[64:65], v19
    ds_read2_b32 v[50:51], v18 offset0:0 offset1:1
    v_lshrrev_b32 v94, 14, v146
    v_and_or_b32 v94, v94, s77, v202
    s_mov_b64 exec, s[90:91]
    ds_add_rtn_u32 v87, v94, v17 offset:20480
    s_mov_b64 exec, -1
    v_mad_u32_u16 v18, v150, 6, v16
    v_mad_u32_u16 v19, v151, 8, v215 op_sel:[1,0,0,0]
    v_and_b32 v18, -4, v18
    ds_read_b64 v[66:67], v19
    ds_read2_b32 v[52:53], v18 offset0:0 offset1:1
    v_lshrrev_b32 v95, 14, v150
    v_and_or_b32 v95, v95, s77, v202
    s_mov_b64 exec, s[92:93]
    ds_add_rtn_u32 v88, v95, v17 offset:20480
    s_mov_b64 exec, -1
    s_cmp_le_i32 s67, 320
    s_cbranch_scc1 L_k2_p6a5
    v_mad_u32_u16 v18, v154, 6, v16
    v_mad_u32_u16 v19, v155, 8, v215 op_sel:[1,0,0,0]
    v_and_b32 v18, -4, v18
    ds_read_b64 v[68:69], v19
    ds_read2_b32 v[54:55], v18 offset0:0 offset1:1
    v_lshrrev_b32 v96, 14, v154
    v_and_or_b32 v96, v96, s77, v202
    s_mov_b64 exec, s[94:95]
    ds_add_rtn_u32 v89, v96, v17 offset:20480
    s_mov_b64 exec, -1
    s_cmp_le_i32 s67, 384
    s_cbranch_scc1 L_k2_p6a5
    v_mad_u32_u16 v18, v158, 6, v16
    v_mad_u32_u16 v19, v159, 8, v215 op_sel:[1,0,0,0]
    v_and_b32 v18, -4, v18
    ds_read_b64 v[70:71], v19
    ds_read2_b32 v[56:57], v18 offset0:0 offset1:1
    v_lshrrev_b32 v97, 14, v158
    v_and_or_b32 v97, v97, s77, v202
    s_mov_b64 exec, s[96:97]
    ds_add_rtn_u32 v90, v97, v17 offset:20480
    s_mov_b64 exec, -1
L_k2_p6a5:
    s_waitcnt lgkmcnt(6)
    v_lshlrev_b32 v75, 4, v134
    v_alignbit_b32 v73, v45, v44, v75
    v_lshrrev_b32 v74, v75, v45
    v_lshlrev_b32 v72, 16, v73
    v_and_b32 v73, s58, v73
    v_lshlrev_b32 v74, 16, v74
    v_lshlrev_b32 v75, 16, v58
    v_and_b32 v76, s58, v58
    v_lshlrev_b32 v77, 16, v59
    v_sub_f32 v72, v75, v72
    v_sub_f32 v73, v76, v73
    v_sub_f32 v74, v77, v74
    v_cvt_pk_bf16_f32 v78, v72, v73
    v_cvt_pk_bf16_f32 v79, v74, 0
    v_mad_u32_u16 v81, v134, s64, 0 op_sel:[1,0,0,0]
    v_dot2_f32_bf16 v80, v79, v79, 0
    v_lshl_or_b32 v132, v78, 16, v81
    v_dot2_f32_bf16 v80, v78, v78, v80
    v_alignbit_b32 v133, v79, v78, 16
    v_and_b32 v83, 0x70000, v134
    v_and_b32 v134, 0xffff, v134
    v_lshl_or_b32 v134, v83, 4, v134
    v_cvt_pk_bf16_f32 v82, v80, 0
    v_lshl_or_b32 v135, v135, 16, v82
    v_lshlrev_b32 v75, 4, v138
    v_alignbit_b32 v73, v47, v46, v75
    v_lshrrev_b32 v74, v75, v47
    v_lshlrev_b32 v72, 16, v73
    v_and_b32 v73, s58, v73
    v_lshlrev_b32 v74, 16, v74
    v_lshlrev_b32 v75, 16, v60
    v_and_b32 v76, s58, v60
    v_lshlrev_b32 v77, 16, v61
    v_sub_f32 v72, v75, v72
    v_sub_f32 v73, v76, v73
    v_sub_f32 v74, v77, v74
    v_cvt_pk_bf16_f32 v78, v72, v73
    v_cvt_pk_bf16_f32 v79, v74, 0
    v_mad_u32_u16 v81, v138, s64, 0 op_sel:[1,0,0,0]
    v_dot2_f32_bf16 v80, v79, v79, 0
    v_lshl_or_b32 v136, v78, 16, v81
    v_dot2_f32_bf16 v80, v78, v78, v80
    v_alignbit_b32 v137, v79, v78, 16
    v_and_b32 v83, 0x70000, v138
    v_and_b32 v138, 0xffff, v138
    v_lshl_or_b32 v138, v83, 4, v138
    v_cvt_pk_bf16_f32 v82, v80, 0
    v_lshl_or_b32 v139, v139, 16, v82
    s_waitcnt lgkmcnt(0)
    v_lshlrev_b32 v75, 4, v142
    v_alignbit_b32 v73, v49, v48, v75
    v_lshrrev_b32 v74, v75, v49
    v_lshlrev_b32 v72, 16, v73
    v_and_b32 v73, s58, v73
    v_lshlrev_b32 v74, 16, v74
    v_lshlrev_b32 v75, 16, v62
    v_and_b32 v76, s58, v62
    v_lshlrev_b32 v77, 16, v63
    v_sub_f32 v72, v75, v72
    v_sub_f32 v73, v76, v73
    v_sub_f32 v74, v77, v74
    v_cvt_pk_bf16_f32 v78, v72, v73
    v_cvt_pk_bf16_f32 v79, v74, 0
    v_mad_u32_u16 v81, v142, s64, 0 op_sel:[1,0,0,0]
    v_dot2_f32_bf16 v80, v79, v79, 0
    v_lshl_or_b32 v140, v78, 16, v81
    v_dot2_f32_bf16 v80, v78, v78, v80
    v_alignbit_b32 v141, v79, v78, 16
    v_and_b32 v83, 0x70000, v142
    v_and_b32 v142, 0xffff, v142
    v_lshl_or_b32 v142, v83, 4, v142
    v_cvt_pk_bf16_f32 v82, v80, 0
    v_lshl_or_b32 v143, v143, 16, v82
    v_lshlrev_b32 v75, 4, v146
    v_alignbit_b32 v73, v51, v50, v75
    v_lshrrev_b32 v74, v75, v51
    v_lshlrev_b32 v72, 16, v73
    v_and_b32 v73, s58, v73
    v_lshlrev_b32 v74, 16, v74
    v_lshlrev_b32 v75, 16, v64
    v_and_b32 v76, s58, v64
    v_lshlrev_b32 v77, 16, v65
    v_sub_f32 v72, v75, v72
    v_sub_f32 v73, v76, v73
    v_sub_f32 v74, v77, v74
    v_cvt_pk_bf16_f32 v78, v72, v73
    v_cvt_pk_bf16_f32 v79, v74, 0
    v_mad_u32_u16 v81, v146, s64, 0 op_sel:[1,0,0,0]
    v_dot2_f32_bf16 v80, v79, v79, 0
    v_lshl_or_b32 v144, v78, 16, v81
    v_dot2_f32_bf16 v80, v78, v78, v80
    v_alignbit_b32 v145, v79, v78, 16
    v_and_b32 v83, 0x70000, v146
    v_and_b32 v146, 0xffff, v146
    v_lshl_or_b32 v146, v83, 4, v146
    v_cvt_pk_bf16_f32 v82, v80, 0
    v_lshl_or_b32 v147, v147, 16, v82
    v_lshlrev_b32 v75, 4, v150
    v_alignbit_b32 v73, v53, v52, v75
    v_lshrrev_b32 v74, v75, v53
    v_lshlrev_b32 v72, 16, v73
    v_and_b32 v73, s58, v73
    v_lshlrev_b32 v74, 16, v74
    v_lshlrev_b32 v75, 16, v66
    v_and_b32 v76, s58, v66
    v_lshlrev_b32 v77, 16, v67
    v_sub_f32 v72, v75, v72
    v_sub_f32 v73, v76, v73
    v_sub_f32 v74, v77, v74
    v_cvt_pk_bf16_f32 v78, v72, v73
    v_cvt_pk_bf16_f32 v79, v74, 0
    v_mad_u32_u16 v81, v150, s64, 0 op_sel:[1,0,0,0]
    v_dot2_f32_bf16 v80, v79, v79, 0
    v_lshl_or_b32 v148, v78, 16, v81
    v_dot2_f32_bf16 v80, v78, v78, v80
    v_alignbit_b32 v149, v79, v78, 16
    v_and_b32 v83, 0x70000, v150
    v_and_b32 v150, 0xffff, v150
    v_lshl_or_b32 v150, v83, 4, v150
    v_cvt_pk_bf16_f32 v82, v80, 0
    v_lshl_or_b32 v151, v151, 16, v82
    s_cmp_le_i32 s67, 320
    s_cbranch_scc1 L_k2_p6b5
    v_lshlrev_b32 v75, 4, v154
    v_alignbit_b32 v73, v55, v54, v75
    v_lshrrev_b32 v74, v75, v55
    v_lshlrev_b32 v72, 16, v73
    v_and_b32 v73, s58, v73
    v_lshlrev_b32 v74, 16, v74
    v_lshlrev_b32 v75, 16, v68
    v_and_b32 v76, s58, v68
    v_lshlrev_b32 v77, 16, v69
    v_sub_f32 v72, v75, v72
    v_sub_f32 v73, v76, v73
    v_sub_f32 v74, v77, v74
    v_cvt_pk_bf16_f32 v78, v72, v73
    v_cvt_pk_bf16_f32 v79, v74, 0
    v_mad_u32_u16 v81, v154, s64, 0 op_sel:[1,0,0,0]
    v_dot2_f32_bf16 v80, v79, v79, 0
    v_lshl_or_b32 v152, v78, 16, v81
    v_dot2_f32_bf16 v80, v78, v78, v80
    v_alignbit_b32 v153, v79, v78, 16
    v_and_b32 v83, 0x70000, v154
    v_and_b32 v154, 0xffff, v154
    v_lshl_or_b32 v154, v83, 4, v154
    v_cvt_pk_bf16_f32 v82, v80, 0
    v_lshl_or_b32 v155, v155, 16, v82
    s_cmp_le_i32 s67, 384
    s_cbranch_scc1 L_k2_p6b5
    v_lshlrev_b32 v75, 4, v158
    v_alignbit_b32 v73, v57, v56, v75
    v_lshrrev_b32 v74, v75, v57
    v_lshlrev_b32 v72, 16, v73
    v_and_b32 v73, s58, v73
    v_lshlrev_b32 v74, 16, v74
    v_lshlrev_b32 v75, 16, v70
    v_and_b32 v76, s58, v70
    v_lshlrev_b32 v77, 16, v71
    v_sub_f32 v72, v75, v72
    v_sub_f32 v73, v76, v73
    v_sub_f32 v74, v77, v74
    v_cvt_pk_bf16_f32 v78, v72, v73
    v_cvt_pk_bf16_f32 v79, v74, 0
    v_mad_u32_u16 v81, v158, s64, 0 op_sel:[1,0,0,0]
    v_dot2_f32_bf16 v80, v79, v79, 0
    v_lshl_or_b32 v156, v78, 16, v81
    v_dot2_f32_bf16 v80, v78, v78, v80
    v_alignbit_b32 v157, v79, v78, 16
    v_and_b32 v83, 0x70000, v158
    v_and_b32 v158, 0xffff, v158
    v_lshl_or_b32 v158, v83, 4, v158
    v_cvt_pk_bf16_f32 v82, v80, 0
    v_lshl_or_b32 v159, v159, 16, v82
L_k2_p6b5:
    v_lshlrev_b32 v16, 2, v1
    s_waitcnt lgkmcnt(0)
    s_barrier
    ds_read_b32 v17, v16 offset:20480
    v_and_b32 v16, 7, v1
    v_cmp_eq_u32 vcc, 7, v16
    v_lshrrev_b32 v60, 3, v1
    v_sub_u32 v60, 7, v60
    v_lshlrev_b32 v61, 5, v16
    v_and_b32 v63, 56, v1
    s_sub_u32 s79, 11, s76
    s_waitcnt lgkmcnt(0)
    v_mov_b32 v18, v17
    s_nop 1
    v_add_u32_dpp v18, v18, v18 quad_perm:[1,0,3,2] row_mask:0xf bank_mask:0xf
    s_nop 1
    v_add_u32_dpp v18, v18, v18 quad_perm:[2,3,0,1] row_mask:0xf bank_mask:0xf
    s_nop 1
    v_add_u32_dpp v18, v18, v18 row_half_mirror row_mask:0xf bank_mask:0xf
    v_add_u32 v19, 31, v18
    v_lshl_add_u32 v60, v18, 3, v60
    v_and_b32 v19, -32, v19
    ds_bpermute_b32 v62, v61, v60
    v_sub_u32 v31, v19, v18
    v_cndmask_b32 v31, 0, v31, vcc
    v_add_u32 v17, v17, v31
    v_mov_b32 v31, v17
    s_nop 1
    v_add_u32_dpp v31, v31, v31 row_shr:1 row_mask:0xf bank_mask:0xf bound_ctrl:0
    s_nop 1
    v_add_u32_dpp v31, v31, v31 row_shr:2 row_mask:0xf bank_mask:0xf bound_ctrl:0
    s_nop 1
    v_add_u32_dpp v31, v31, v31 row_shr:4 row_mask:0xf bank_mask:0xf bound_ctrl:0
    s_nop 1
    v_add_u32_dpp v31, v31, v31 row_shr:8 row_mask:0xf bank_mask:0xf bound_ctrl:0
    s_nop 1
    v_add_u32_dpp v31, v31, v31 row_bcast:15 row_mask:0xa bank_mask:0xf
    s_nop 1
    v_add_u32_dpp v31, v31, v31 row_bcast:31 row_mask:0xc bank_mask:0xf
    v_sub_u32 v31, v31, v17
    ds_bpermute_b32 v68, v91, v31
    ds_bpermute_b32 v69, v92, v31
    ds_bpermute_b32 v70, v93, v31
    ds_bpermute_b32 v71, v94, v31
    ds_bpermute_b32 v72, v95, v31
    ds_bpermute_b32 v73, v96, v31
    ds_bpermute_b32 v74, v97, v31
    s_cmp_lt_u32 s76, 4
    s_cselect_b32 s79, s76, s79
    s_waitcnt lgkmcnt(7)
    v_cmp_gt_u32 vcc, v62, v60
    s_nop 1
    v_lshrrev_b64 v[64:65], v63, vcc
    v_and_b32 v64, 0xff, v64
    v_bcnt_u32_b32 v64, v64, 0
    v_cmp_eq_u32 vcc, s79, v64
    s_nop 0
    s_ff1_i32_b64 s77, vcc
    s_lshr_b32 s61, s77, 3
    s_cmp_eq_u32 s66, 0
    s_cselect_b32 s61, s59, s61
    s_lshl_b32 s77, s61, 3
    v_readlane_b32 s52, v18, s77
    v_readlane_b32 s55, v19, s77
    v_readlane_b32 s54, v31, s77
    s_waitcnt lgkmcnt(0)
    v_add_lshl_u32 v68, v68, v84, 4
    s_mov_b64 exec, s[84:85]
    ds_write_b128 v68, v[132:135] offset:22528
    v_add_lshl_u32 v69, v69, v85, 4
    s_mov_b64 exec, s[86:87]
    ds_write_b128 v69, v[136:139] offset:22528
    v_add_lshl_u32 v70, v70, v86, 4
    s_mov_b64 exec, s[88:89]
    ds_write_b128 v70, v[140:143] offset:22528
    v_add_lshl_u32 v71, v71, v87, 4
    s_mov_b64 exec, s[90:91]
    ds_write_b128 v71, v[144:147] offset:22528
    v_add_lshl_u32 v72, v72, v88, 4
    s_mov_b64 exec, s[92:93]
    ds_write_b128 v72, v[148:151] offset:22528
    s_cmp_le_i32 s67, 320
    s_cbranch_scc1 L_k2_p85
    s_mov_b64 exec, -1
    v_add_lshl_u32 v73, v73, v89, 4
    s_mov_b64 exec, s[94:95]
    ds_write_b128 v73, v[152:155] offset:22528
    s_cmp_le_i32 s67, 384
    s_cbranch_scc1 L_k2_p85
    s_mov_b64 exec, -1
    v_add_lshl_u32 v74, v74, v90, 4
    s_mov_b64 exec, s[96:97]
    ds_write_b128 v74, v[156:159] offset:22528
L_k2_p85:
    s_mov_b64 exec, -1
    s_sub_u32 s77, s55, s52
    s_add_u32 s79, s54, s52
    v_add_lshl_u32 v17, s79, v1, 4
    v_cmp_gt_u32 vcc, s77, v1
    s_mul_i32 s78, s61, 2560
    s_add_u32 s77, s78, 2240
    v_mov_b32 v84, s77
    v_mov_b32 v85, 0
    v_mov_b32 v86, 0x70ffff
    v_mov_b32 v87, 0
    s_mov_b64 exec, vcc
    ds_write_b128 v17, v[84:87] offset:22528
    s_mov_b64 exec, -1
    s_lshr_b32 s56, s55, 5
    s_min_u32 s56, s56, 104
    s_and_b32 s65, s52, 31
    s_lshl_b32 s77, s54, 4
    v_add_u32 v12, s77, v212
    s_add_u32 s77, s77, 22528
    v_add_u32 v13, s77, v213
    v_add_u32 v11, s78, v214
    s_cmp_eq_u32 s66, 0
    s_cbranch_scc1 L_k2_noxb
    s_mul_i32 s78, s61, 1536
    s_add_u32 s78, s78, 88064
    v_lshl_add_u32 v18, v1, 2, s78
    ds_read_b32 v32, v18
    ds_read_b32 v33, v18 offset:256
    ds_read_b32 v34, v18 offset:512
    ds_read_b32 v36, v18 offset:768
    ds_read_b32 v37, v18 offset:1024
    ds_read_b32 v38, v18 offset:1280
    v_mov_b32 v35, v206
    v_mov_b32 v39, v207
    s_mov_b32 s66, 0
    s_mov_b32 s59, s61
L_k2_noxb:
    s_movk_i32 s64, 128
    s_waitcnt lgkmcnt(0)
    s_barrier
    s_sub_u32 s72, s40, 3072
    s_subb_u32 s73, s41, 0
    s_mov_b32 s74, 1283072
    s_mov_b32 s75, 0x20000
    s_mov_b32 m0, s57
    s_cmp_eq_u32 s56, 0
    s_cbranch_scc1 L_k2_tilesdone
    ds_read2_b32 v[24:25], v13 offset0:0 offset1:4
    ds_read2_b32 v[26:27], v13 offset0:8 offset1:12
    ds_read_b128 v[40:43], v12 offset:22528
    v_add_u32 v13, 512, v13
    v_add_u32 v12, 512, v12
    s_waitcnt lgkmcnt(1)
    v_mad_u32_u16 v20, v24, s64, v6
    v_mad_u32_u16 v21, v25, s64, v7
    v_mad_u32_u16 v22, v26, s64, v8
    v_mad_u32_u16 v23, v27, s64, v9
    buffer_load_dwordx4 v20, s[72:75], 0 offen offset:0 lds
    buffer_load_dwordx4 v21, s[72:75], 0 offen offset:1024 lds
    buffer_load_dwordx4 v22, s[72:75], 0 offen offset:2048 lds
    buffer_load_dwordx4 v23, s[72:75], 0 offen offset:3072 lds
    ds_read2_b32 v[24:25], v13 offset0:0 offset1:4
    ds_read2_b32 v[26:27], v13 offset0:8 offset1:12
    v_add_u32 v13, 512, v13
    s_waitcnt lgkmcnt(2)
    v_mad_u32_u16 v28, v40, 1, v10
    v_and_or_b32 v29, v40, s58, v14
    v_lshrrev_b32 v30, 16, v42
    v_cndmask_b32 v29, v29, v41, s[80:81]
    ds_read_b96 v[40:42], v30 offset:20992
    ds_write_b16 v28, v29
    ds_write_b16_d16_hi v28, v29 offset:80
    s_waitcnt vmcnt(0)
    ds_read_b128 v[44:47], v2
    ds_read_b128 v[48:51], v3
    ds_read_b128 v[52:55], v4
    ds_read_b128 v[56:59], v5
    s_waitcnt lgkmcnt(0)
    v_mad_u32_u16 v20, v24, s64, v6
    v_mad_u32_u16 v21, v25, s64, v7
    v_mad_u32_u16 v22, v26, s64, v8
    v_mad_u32_u16 v23, v27, s64, v9
    v_mfma_f32_32x32x16_bf16 v[132:147], v[44:47], v[164:167], 0
    buffer_load_dwordx4 v20, s[72:75], 0 offen offset:0 lds
    v_mfma_f32_32x32x16_bf16 v[132:147], v[48:51], v[168:171], v[132:147]
    buffer_load_dwordx4 v21, s[72:75], 0 offen offset:1024 lds
    v_mfma_f32_32x32x16_bf16 v[132:147], v[52:55], v[172:175], v[132:147]
    buffer_load_dwordx4 v22, s[72:75], 0 offen offset:2048 lds
    v_mfma_f32_32x32x16_bf16 v[132:147], v[56:59], v[176:179], v[132:147]
    buffer_load_dwordx4 v23, s[72:75], 0 offen offset:3072 lds
    v_mfma_f32_32x32x16_bf16 v[132:147], v[40:43], v[32:35], v[132:147]
    s_nop 7
    s_nop 3
L_k2_loop:
    v_mfma_f32_32x32x16_bf16 v[148:163], v[44:47], v[180:183], 0
    v_exp_f32 v84, v132
    ds_read_b128 v[60:63], v11
    v_exp_f32 v85, v133
    ds_read_b128 v[64:67], v11 offset:32
    v_exp_f32 v86, v134
    ds_write_b16 v28, v15
    v_exp_f32 v87, v135
    ds_write_b16 v28, v15 offset:80
    v_mfma_f32_32x32x16_bf16 v[148:163], v[48:51], v[184:187], v[148:163]
    v_exp_f32 v88, v136
    v_exp_f32 v89, v137
    v_exp_f32 v90, v138
    v_exp_f32 v91, v139
    v_pk_add_f32 v[84:85], v[84:85], 1.0 op_sel_hi:[1,0]
    v_pk_add_f32 v[86:87], v[86:87], 1.0 op_sel_hi:[1,0]
    v_pk_add_f32 v[88:89], v[88:89], 1.0 op_sel_hi:[1,0]
    v_pk_add_f32 v[90:91], v[90:91], 1.0 op_sel_hi:[1,0]
    v_mfma_f32_32x32x16_bf16 v[148:163], v[52:55], v[188:191], v[148:163]
    v_rcp_f32 v84, v84
    v_rcp_f32 v85, v85
    v_rcp_f32 v86, v86
    v_rcp_f32 v87, v87
    v_mfma_f32_32x32x16_bf16 v[148:163], v[56:59], v[192:195], v[148:163]
    v_rcp_f32 v88, v88
    v_rcp_f32 v89, v89
    v_rcp_f32 v90, v90
    v_rcp_f32 v91, v91
    v_pk_mul_f32 v[84:85], v[84:85], v[132:133]
    v_pk_mul_f32 v[86:87], v[86:87], v[134:135]
    v_pk_mul_f32 v[88:89], v[88:89], v[136:137]
    v_pk_mul_f32 v[90:91], v[90:91], v[138:139]
    v_cvt_pk_bf16_f32 v68, v84, v85
    v_cvt_pk_bf16_f32 v69, v86, v87
    v_cvt_pk_bf16_f32 v70, v88, v89
    v_cvt_pk_bf16_f32 v71, v90, v91
    s_cmp_eq_u32 s56, 1
    s_cbranch_scc0 L_k2_q1
    s_sub_u32 s77, s65, 1
    s_cmp_lt_u32 s77, 16
    s_cbranch_scc1 L_k2_half
L_k2_q1:
    v_mfma_f32_32x32x16_bf16 v[148:163], v[40:43], v[36:39], v[148:163]
    v_exp_f32 v92, v140
    v_exp_f32 v93, v141
    v_exp_f32 v94, v142
    v_exp_f32 v95, v143
    s_waitcnt vmcnt(0) lgkmcnt(0)
    v_mfma_f32_32x32x16_bf16 v[100:115], v[60:63], v[68:71], v[100:115]
    v_exp_f32 v96, v144
    ds_read_b128 v[44:47], v2
    v_exp_f32 v97, v145
    ds_read_b128 v[48:51], v3
    v_exp_f32 v98, v146
    ds_read_b128 v[52:55], v4
    v_exp_f32 v99, v147
    ds_read_b128 v[56:59], v5
    v_pk_add_f32 v[92:93], v[92:93], 1.0 op_sel_hi:[1,0]
    ds_read_b128 v[40:43], v12 offset:22528
    v_pk_add_f32 v[94:95], v[94:95], 1.0 op_sel_hi:[1,0]
    ds_read2_b32 v[24:25], v13 offset0:0 offset1:4
    v_pk_add_f32 v[96:97], v[96:97], 1.0 op_sel_hi:[1,0]
    ds_read2_b32 v[26:27], v13 offset0:8 offset1:12
    v_pk_add_f32 v[98:99], v[98:99], 1.0 op_sel_hi:[1,0]
    v_add_u32 v12, 512, v12
    v_rcp_f32 v92, v92
    v_rcp_f32 v93, v93
    v_rcp_f32 v94, v94
    v_rcp_f32 v95, v95
    v_rcp_f32 v96, v96
    v_rcp_f32 v97, v97
    v_rcp_f32 v98, v98
    v_rcp_f32 v99, v99
    v_add_u32 v13, 512, v13
    v_pk_mul_f32 v[92:93], v[92:93], v[140:141]
    v_pk_mul_f32 v[94:95], v[94:95], v[142:143]
    v_pk_mul_f32 v[96:97], v[96:97], v[144:145]
    v_pk_mul_f32 v[98:99], v[98:99], v[146:147]
    v_cvt_pk_bf16_f32 v72, v92, v93
    v_cvt_pk_bf16_f32 v73, v94, v95
    v_cvt_pk_bf16_f32 v74, v96, v97
    v_cvt_pk_bf16_f32 v75, v98, v99
    s_waitcnt lgkmcnt(0)
    v_mad_u32_u16 v28, v40, 1, v10
    v_and_or_b32 v29, v40, s58, v14
    v_lshrrev_b32 v30, 16, v42
    v_cndmask_b32 v29, v29, v41, s[80:81]
    v_mad_u32_u16 v20, v24, s64, v6
    v_mad_u32_u16 v21, v25, s64, v7
    v_mad_u32_u16 v22, v26, s64, v8
    v_mad_u32_u16 v23, v27, s64, v9
    v_mfma_f32_32x32x16_bf16 v[132:147], v[44:47], v[164:167], 0
    v_exp_f32 v84, v148
    ds_read_b96 v[40:42], v30 offset:20992
    v_exp_f32 v85, v149
    s_cmp_gt_u32 s56, 1
    s_cselect_b64 exec, -1, 0
    ds_write_b16 v28, v29
    ds_write_b16_d16_hi v28, v29 offset:80
    s_mov_b64 exec, -1
    v_exp_f32 v86, v150
    buffer_load_dwordx4 v20, s[72:75], 0 offen offset:0 lds
    v_exp_f32 v87, v151
    buffer_load_dwordx4 v21, s[72:75], 0 offen offset:1024 lds
    v_mfma_f32_32x32x16_bf16 v[100:115], v[64:67], v[72:75], v[100:115]
    v_exp_f32 v88, v152
    v_exp_f32 v89, v153
    buffer_load_dwordx4 v22, s[72:75], 0 offen offset:2048 lds
    v_exp_f32 v90, v154
    buffer_load_dwordx4 v23, s[72:75], 0 offen offset:3072 lds
    v_exp_f32 v91, v155
    v_pk_add_f32 v[84:85], v[84:85], 1.0 op_sel_hi:[1,0]
    v_pk_add_f32 v[86:87], v[86:87], 1.0 op_sel_hi:[1,0]
    v_pk_add_f32 v[88:89], v[88:89], 1.0 op_sel_hi:[1,0]
    v_pk_add_f32 v[90:91], v[90:91], 1.0 op_sel_hi:[1,0]
    v_mfma_f32_32x32x16_bf16 v[132:147], v[48:51], v[168:171], v[132:147]
    v_rcp_f32 v84, v84
    v_rcp_f32 v85, v85
    v_rcp_f32 v86, v86
    v_rcp_f32 v87, v87
    v_mfma_f32_32x32x16_bf16 v[132:147], v[52:55], v[172:175], v[132:147]
    v_rcp_f32 v88, v88
    v_rcp_f32 v89, v89
    v_rcp_f32 v90, v90
    v_rcp_f32 v91, v91
    v_pk_mul_f32 v[84:85], v[84:85], v[148:149]
    v_pk_mul_f32 v[86:87], v[86:87], v[150:151]
    v_pk_mul_f32 v[88:89], v[88:89], v[152:153]
    v_pk_mul_f32 v[90:91], v[90:91], v[154:155]
    v_cvt_pk_bf16_f32 v76, v84, v85
    v_cvt_pk_bf16_f32 v77, v86, v87
    v_cvt_pk_bf16_f32 v78, v88, v89
    v_cvt_pk_bf16_f32 v79, v90, v91
    v_mfma_f32_32x32x16_bf16 v[132:147], v[56:59], v[176:179], v[132:147]
    v_exp_f32 v92, v156
    v_exp_f32 v93, v157
    v_exp_f32 v94, v158
    v_exp_f32 v95, v159
    v_mfma_f32_32x32x16_bf16 v[116:131], v[60:63], v[76:79], v[116:131]
    v_exp_f32 v96, v160
    v_exp_f32 v97, v161
    v_exp_f32 v98, v162
    v_exp_f32 v99, v163
    v_pk_add_f32 v[92:93], v[92:93], 1.0 op_sel_hi:[1,0]
    v_pk_add_f32 v[94:95], v[94:95], 1.0 op_sel_hi:[1,0]
    v_pk_add_f32 v[96:97], v[96:97], 1.0 op_sel_hi:[1,0]
    v_pk_add_f32 v[98:99], v[98:99], 1.0 op_sel_hi:[1,0]
    s_waitcnt lgkmcnt(0)
    v_mfma_f32_32x32x16_bf16 v[132:147], v[40:43], v[32:35], v[132:147]
    v_rcp_f32 v92, v92
    v_rcp_f32 v93, v93
    v_rcp_f32 v94, v94
    v_rcp_f32 v95, v95
    v_rcp_f32 v96, v96
    v_rcp_f32 v97, v97
    v_rcp_f32 v98, v98
    v_rcp_f32 v99, v99
    v_pk_mul_f32 v[92:93], v[92:93], v[156:157]
    v_pk_mul_f32 v[94:95], v[94:95], v[158:159]
    v_pk_mul_f32 v[96:97], v[96:97], v[160:161]
    v_pk_mul_f32 v[98:99], v[98:99], v[162:163]
    v_cvt_pk_bf16_f32 v80, v92, v93
    v_cvt_pk_bf16_f32 v81, v94, v95
    v_cvt_pk_bf16_f32 v82, v96, v97
    v_cvt_pk_bf16_f32 v83, v98, v99
    s_sub_u32 s56, s56, 1
    s_cmp_eq_u32 s56, 0
    v_mfma_f32_32x32x16_bf16 v[116:131], v[64:67], v[80:83], v[116:131]
    s_cbranch_scc0 L_k2_loop
    s_branch L_k2_tilesdone
L_k2_half:
    v_mfma_f32_32x32x16_bf16 v[148:163], v[40:43], v[36:39], v[148:163]
    s_waitcnt lgkmcnt(0)
    v_mfma_f32_32x32x16_bf16 v[100:115], v[60:63], v[68:71], v[100:115]
    s_nop 7
    s_nop 3
    v_exp_f32 v84, v148
    v_exp_f32 v85, v149
    v_exp_f32 v86, v150
    v_exp_f32 v87, v151
    v_exp_f32 v88, v152
    v_exp_f32 v89, v153
    v_exp_f32 v90, v154
    v_exp_f32 v91, v155
    v_pk_add_f32 v[84:85], v[84:85], 1.0 op_sel_hi:[1,0]
    v_pk_add_f32 v[86:87], v[86:87], 1.0 op_sel_hi:[1,0]
    v_pk_add_f32 v[88:89], v[88:89], 1.0 op_sel_hi:[1,0]
    v_pk_add_f32 v[90:91], v[90:91], 1.0 op_sel_hi:[1,0]
    v_rcp_f32 v84, v84
    v_rcp_f32 v85, v85
    v_rcp_f32 v86, v86
    v_rcp_f32 v87, v87
    v_rcp_f32 v88, v88
    v_rcp_f32 v89, v89
    v_rcp_f32 v90, v90
    v_rcp_f32 v91, v91
    v_pk_mul_f32 v[84:85], v[84:85], v[148:149]
    v_pk_mul_f32 v[86:87], v[86:87], v[150:151]
    v_pk_mul_f32 v[88:89], v[88:89], v[152:153]
    v_pk_mul_f32 v[90:91], v[90:91], v[154:155]
    v_cvt_pk_bf16_f32 v76, v84, v85
    v_cvt_pk_bf16_f32 v77, v86, v87
    v_cvt_pk_bf16_f32 v78, v88, v89
    v_cvt_pk_bf16_f32 v79, v90, v91
    s_nop 1
    v_mfma_f32_32x32x16_bf16 v[116:131], v[60:63], v[76:79], v[116:131]
L_k2_tilesdone:
    s_add_u32 s53, s53, s49
    s_cmp_ge_u32 s53, s50
    s_cbranch_scc0 L_k2_more
    s_mov_b32 s79, 3207688728
    s_mul_i32 s77, s61, 640
    s_add_u32 s77, s77, 113664
    v_add_u32 v19, s77, v197
    s_mul_i32 s77, s61, 80
    v_add_u32 v31, s77, v198
    s_mov_b32 s44, s34
    s_mov_b32 s45, s35
    s_mov_b32 s46, 1340000
    s_mov_b32 s47, 0x20000
    s_nop 3
    v_mul_f32 v68, v204, v101
    v_fmac_f32 v68, v205, v117
    v_mul_f32 v69, v204, v102
    v_fmac_f32 v69, v205, v118
    v_mul_f32 v70, v204, v103
    v_fmac_f32 v70, v205, v119
    v_mul_f32 v71, v204, v105
    v_fmac_f32 v71, v205, v121
    v_mul_f32 v72, v204, v106
    v_fmac_f32 v72, v205, v122
    v_mul_f32 v73, v204, v107
    v_fmac_f32 v73, v205, v123
    v_mul_f32 v74, v204, v109
    v_fmac_f32 v74, v205, v125
    v_mul_f32 v75, v204, v110
    v_fmac_f32 v75, v205, v126
    v_mul_f32 v76, v204, v111
    v_fmac_f32 v76, v205, v127
    v_mul_f32 v84, s79, v100
    v_mul_f32 v85, s79, v116
    v_cvt_pk_bf16_f32 v84, v84, v85
    v_mul_f32 v86, s79, v104
    v_mul_f32 v87, s79, v120
    v_cvt_pk_bf16_f32 v86, v86, v87
    v_mul_f32 v88, s79, v108
    v_mul_f32 v89, s79, v124
    v_cvt_pk_bf16_f32 v88, v88, v89
    ds_write_b16 v19, v84 offset:0
    ds_write_b16_d16_hi v19, v84 offset:64
    ds_write_b16 v19, v86 offset:256
    ds_write_b16_d16_hi v19, v86 offset:320
    s_mov_b32 exec_hi, 0
    ds_write_b16 v19, v88 offset:512
    ds_write_b16_d16_hi v19, v88 offset:576
    s_mov_b64 exec, -1
    v_add_f32_dpp v68, v68, v68 row_shr:1 row_mask:0xf bank_mask:0xf bound_ctrl:0
    v_add_f32_dpp v69, v69, v69 row_shr:1 row_mask:0xf bank_mask:0xf bound_ctrl:0
    v_add_f32_dpp v70, v70, v70 row_shr:1 row_mask:0xf bank_mask:0xf bound_ctrl:0
    v_add_f32_dpp v71, v71, v71 row_shr:1 row_mask:0xf bank_mask:0xf bound_ctrl:0
    v_add_f32_dpp v72, v72, v72 row_shr:1 row_mask:0xf bank_mask:0xf bound_ctrl:0
    v_add_f32_dpp v73, v73, v73 row_shr:1 row_mask:0xf bank_mask:0xf bound_ctrl:0
    v_add_f32_dpp v74, v74, v74 row_shr:1 row_mask:0xf bank_mask:0xf bound_ctrl:0
    v_add_f32_dpp v75, v75, v75 row_shr:1 row_mask:0xf bank_mask:0xf bound_ctrl:0
    v_add_f32_dpp v76, v76, v76 row_shr:1 row_mask:0xf bank_mask:0xf bound_ctrl:0
    v_add_f32_dpp v68, v68, v68 row_shr:2 row_mask:0xf bank_mask:0xf bound_ctrl:0
    v_add_f32_dpp v69, v69, v69 row_shr:2 row_mask:0xf bank_mask:0xf bound_ctrl:0
    v_add_f32_dpp v70, v70, v70 row_shr:2 row_mask:0xf bank_mask:0xf bound_ctrl:0
    v_add_f32_dpp v71, v71, v71 row_shr:2 row_mask:0xf bank_mask:0xf bound_ctrl:0
    v_add_f32_dpp v72, v72, v72 row_shr:2 row_mask:0xf bank_mask:0xf bound_ctrl:0
    v_add_f32_dpp v73, v73, v73 row_shr:2 row_mask:0xf bank_mask:0xf bound_ctrl:0
    v_add_f32_dpp v74, v74, v74 row_shr:2 row_mask:0xf bank_mask:0xf bound_ctrl:0
    v_add_f32_dpp v75, v75, v75 row_shr:2 row_mask:0xf bank_mask:0xf bound_ctrl:0
    v_add_f32_dpp v76, v76, v76 row_shr:2 row_mask:0xf bank_mask:0xf bound_ctrl:0
    v_add_f32_dpp v68, v68, v68 row_shr:4 row_mask:0xf bank_mask:0xf bound_ctrl:0
    v_add_f32_dpp v69, v69, v69 row_shr:4 row_mask:0xf bank_mask:0xf bound_ctrl:0
    v_add_f32_dpp v70, v70, v70 row_shr:4 row_mask:0xf bank_mask:0xf bound_ctrl:0
    v_add_f32_dpp v71, v71, v71 row_shr:4 row_mask:0xf bank_mask:0xf bound_ctrl:0
    v_add_f32_dpp v72, v72, v72 row_shr:4 row_mask:0xf bank_mask:0xf bound_ctrl:0
    v_add_f32_dpp v73, v73, v73 row_shr:4 row_mask:0xf bank_mask:0xf bound_ctrl:0
    v_add_f32_dpp v74, v74, v74 row_shr:4 row_mask:0xf bank_mask:0xf bound_ctrl:0
    v_add_f32_dpp v75, v75, v75 row_shr:4 row_mask:0xf bank_mask:0xf bound_ctrl:0
    v_add_f32_dpp v76, v76, v76 row_shr:4 row_mask:0xf bank_mask:0xf bound_ctrl:0
    v_add_f32_dpp v68, v68, v68 row_shr:8 row_mask:0xf bank_mask:0xf bound_ctrl:0
    v_add_f32_dpp v69, v69, v69 row_shr:8 row_mask:0xf bank_mask:0xf bound_ctrl:0
    v_add_f32_dpp v70, v70, v70 row_shr:8 row_mask:0xf bank_mask:0xf bound_ctrl:0
    v_add_f32_dpp v71, v71, v71 row_shr:8 row_mask:0xf bank_mask:0xf bound_ctrl:0
    v_add_f32_dpp v72, v72, v72 row_shr:8 row_mask:0xf bank_mask:0xf bound_ctrl:0
    v_add_f32_dpp v73, v73, v73 row_shr:8 row_mask:0xf bank_mask:0xf bound_ctrl:0
    v_add_f32_dpp v74, v74, v74 row_shr:8 row_mask:0xf bank_mask:0xf bound_ctrl:0
    v_add_f32_dpp v75, v75, v75 row_shr:8 row_mask:0xf bank_mask:0xf bound_ctrl:0
    v_add_f32_dpp v76, v76, v76 row_shr:8 row_mask:0xf bank_mask:0xf bound_ctrl:0
    v_add_f32_dpp v68, v68, v68 row_bcast:15 row_mask:0xa bank_mask:0xf
    v_add_f32_dpp v69, v69, v69 row_bcast:15 row_mask:0xa bank_mask:0xf
    v_add_f32_dpp v70, v70, v70 row_bcast:15 row_mask:0xa bank_mask:0xf
    v_add_f32_dpp v71, v71, v71 row_bcast:15 row_mask:0xa bank_mask:0xf
    v_add_f32_dpp v72, v72, v72 row_bcast:15 row_mask:0xa bank_mask:0xf
    v_add_f32_dpp v73, v73, v73 row_bcast:15 row_mask:0xa bank_mask:0xf
    v_add_f32_dpp v74, v74, v74 row_bcast:15 row_mask:0xa bank_mask:0xf
    v_add_f32_dpp v75, v75, v75 row_bcast:15 row_mask:0xa bank_mask:0xf
    v_add_f32_dpp v76, v76, v76 row_bcast:15 row_mask:0xa bank_mask:0xf
    s_mov_b32 exec_lo, 0x80000000
    s_mov_b32 exec_hi, 0x80000000
    ds_write_b32 v31, v68 offset:21248
    ds_write_b32 v31, v69 offset:21252
    ds_write_b32 v31, v70 offset:21256
    ds_write_b32 v31, v71 offset:21280
    ds_write_b32 v31, v72 offset:21284
    ds_write_b32 v31, v73 offset:21288
    s_mov_b32 exec_hi, 0
    ds_write_b32 v31, v74 offset:21312
    ds_write_b32 v31, v75 offset:21316
    ds_write_b32 v31, v76 offset:21320
    s_mov_b64 exec, -1
    s_and_b32 s77, s76, 3
    s_lshl_b32 s77, s77, 5
    s_add_u32 s78, s77, 118784
    v_add_u32 v18, s78, v199
    s_cmp_lt_u32 s76, 4
    s_cselect_b32 s79, 0, 4096
    s_add_u32 s78, s79, 108544
    v_add_u32 v84, s78, v200
    s_add_u32 s79, s79, s77
    v_add_u32 v85, s79, v201
    v_add_u32 v86, 108544, v85
    s_mov_b32 s79, 3216550459
    s_mul_i32 s78, s2, 5120
    s_waitcnt vmcnt(0) lgkmcnt(0)
    s_barrier
    ds_read_b64_tr_b16 v[132:133], v18 offset:0
    ds_read_b64_tr_b16 v[134:135], v18 offset:512
    ds_read_b64_tr_b16 v[136:137], v18 offset:4096
    ds_read_b64_tr_b16 v[138:139], v18 offset:4608
    ds_read_b64_tr_b16 v[140:141], v18 offset:8192
    ds_read_b64_tr_b16 v[142:143], v18 offset:8704
    ds_read_b64_tr_b16 v[144:145], v18 offset:12288
    ds_read_b64_tr_b16 v[146:147], v18 offset:12800
    ds_read_b128 v[164:167], v84 offset:0
    ds_read_b128 v[168:171], v84 offset:64
    ds_read_b128 v[172:175], v84 offset:5120
    ds_read_b128 v[176:179], v84 offset:5184
    ds_read_b64 v[88:89], v86
    s_cmp_lt_u32 s76, 4
    s_cbranch_scc0 L_k2_hiw
    ds_read_b128 v[180:183], v84 offset:2048
    ds_read_b128 v[184:187], v84 offset:2112
    ds_read_b128 v[188:191], v84 offset:7168
    ds_read_b128 v[192:195], v84 offset:7232
    ds_read_b64 v[90:91], v86 offset:2048
    v_mul_u32_u24 v92, 171, v0
    v_lshrrev_b32 v92, 9, v92
    v_mad_i32_i24 v93, v92, -3, v0
    v_lshlrev_b32 v94, 4, v92
    v_lshl_add_u32 v94, v93, 2, v94
    ds_read_b32 v96, v94 offset:21248
    v_lshlrev_b32 v95, 1, v0
    s_waitcnt lgkmcnt(6)
    v_mfma_f32_16x16x32_bf16 v[100:103], v[132:135], v[164:167], 0
    v_mfma_f32_16x16x32_bf16 v[100:103], v[136:139], v[168:171], v[100:103]
    v_mfma_f32_16x16x32_bf16 v[100:103], v[140:143], v[172:175], v[100:103]
    v_mfma_f32_16x16x32_bf16 v[100:103], v[144:147], v[176:179], v[100:103]
    s_waitcnt lgkmcnt(0)
    v_mfma_f32_16x16x32_bf16 v[104:107], v[132:135], v[180:183], 0
    v_mfma_f32_16x16x32_bf16 v[104:107], v[136:139], v[184:187], v[104:107]
    v_mfma_f32_16x16x32_bf16 v[104:107], v[140:143], v[188:191], v[104:107]
    v_mfma_f32_16x16x32_bf16 v[104:107], v[144:147], v[192:195], v[104:107]
    v_lshlrev_b32 v72, 16, v88
    v_and_b32 v73, s58, v88
    v_lshlrev_b32 v74, 16, v89
    v_and_b32 v75, s58, v89
    v_mul_f32 v68, s79, v100
    v_mul_f32 v69, s79, v101
    v_mul_f32 v70, s79, v102
    v_mul_f32 v71, s79, v103
    v_exp_f32 v68, v68
    v_exp_f32 v69, v69
    v_exp_f32 v70, v70
    v_exp_f32 v71, v71
    v_add_f32 v68, 1.0, v68
    v_add_f32 v69, 1.0, v69
    v_add_f32 v70, 1.0, v70
    v_add_f32 v71, 1.0, v71
    v_rcp_f32 v68, v68
    v_rcp_f32 v69, v69
    v_rcp_f32 v70, v70
    v_rcp_f32 v71, v71
    v_fma_f32 v72, v100, v68, v72
    v_fma_f32 v73, v101, v69, v73
    v_fma_f32 v74, v102, v70, v74
    v_fma_f32 v75, v103, v71, v75
    v_cvt_pk_bf16_f32 v100, v72, v73
    v_cvt_pk_bf16_f32 v101, v74, v75
    buffer_store_dwordx2 v[100:101], v85, s[44:47], s78 offen
    v_lshlrev_b32 v80, 16, v90
    v_and_b32 v81, s58, v90
    v_lshlrev_b32 v82, 16, v91
    v_and_b32 v83, s58, v91
    v_mul_f32 v76, s79, v104
    v_mul_f32 v77, s79, v105
    v_mul_f32 v78, s79, v106
    v_mul_f32 v79, s79, v107
    v_exp_f32 v76, v76
    v_exp_f32 v77, v77
    v_exp_f32 v78, v78
    v_exp_f32 v79, v79
    v_add_f32 v76, 1.0, v76
    v_add_f32 v77, 1.0, v77
    v_add_f32 v78, 1.0, v78
    v_add_f32 v79, 1.0, v79
    v_rcp_f32 v76, v76
    v_rcp_f32 v77, v77
    v_rcp_f32 v78, v78
    v_rcp_f32 v79, v79
    v_fma_f32 v80, v104, v76, v80
    v_fma_f32 v81, v105, v77, v81
    v_fma_f32 v82, v106, v78, v82
    v_fma_f32 v83, v107, v79, v83
    v_cvt_pk_bf16_f32 v104, v80, v81
    v_cvt_pk_bf16_f32 v105, v82, v83
    buffer_store_dwordx2 v[104:105], v85, s[44:47], s78 offen offset:2048
    s_movk_i32 s77, 120
    v_cmp_gt_u32 vcc, s77, v0
    s_nop 0
    s_and_b64 exec, exec, vcc
    s_cbranch_scc0 L_k2_fin
    s_mul_i32 s78, s2, 240
    s_add_u32 s78, s78, 1280000
    v_lshlrev_b32 v97, 16, v208
    v_add_f32 v97, v97, v96
    v_cvt_pk_bf16_f32 v97, v97, 0
    buffer_store_short v97, v95, s[44:47], s78 offen
    s_branch L_k2_fin
L_k2_hiw:
    s_waitcnt lgkmcnt(0)
    v_mfma_f32_16x16x32_bf16 v[100:103], v[132:135], v[164:167], 0
    v_mfma_f32_16x16x32_bf16 v[100:103], v[136:139], v[168:171], v[100:103]
    v_mfma_f32_16x16x32_bf16 v[100:103], v[140:143], v[172:175], v[100:103]
    v_mfma_f32_16x16x32_bf16 v[100:103], v[144:147], v[176:179], v[100:103]
    v_lshlrev_b32 v72, 16, v88
    v_and_b32 v73, s58, v88
    v_lshlrev_b32 v74, 16, v89
    v_and_b32 v75, s58, v89
    s_nop 3
    v_mul_f32 v68, s79, v100
    v_mul_f32 v69, s79, v101
    v_mul_f32 v70, s79, v102
    v_mul_f32 v71, s79, v103
    v_exp_f32 v68, v68
    v_exp_f32 v69, v69
    v_exp_f32 v70, v70
    v_exp_f32 v71, v71
    v_add_f32 v68, 1.0, v68
    v_add_f32 v69, 1.0, v69
    v_add_f32 v70, 1.0, v70
    v_add_f32 v71, 1.0, v71
    v_rcp_f32 v68, v68
    v_rcp_f32 v69, v69
    v_rcp_f32 v70, v70
    v_rcp_f32 v71, v71
    v_fma_f32 v72, v100, v68, v72
    v_fma_f32 v73, v101, v69, v73
    v_fma_f32 v74, v102, v70, v74
    v_fma_f32 v75, v103, v71, v75
    v_cvt_pk_bf16_f32 v100, v72, v73
    v_cvt_pk_bf16_f32 v101, v74, v75
    v_and_b32 v17, 15, v1
    v_cmp_gt_u32 vcc, 8, v17
    s_nop 0
    s_and_b64 exec, exec, vcc
    buffer_store_dwordx2 v[100:101], v85, s[44:47], s78 offen
L_k2_fin:
    s_mov_b64 exec, -1
    s_endpgm
L_k2_slowfirst:
    s_branch L_k2_batch
L_k2_more:
    s_waitcnt vmcnt(0) lgkmcnt(0)
    s_barrier
    v_lshlrev_b32 v16, 2, v1
    ds_write_b32 v16, v15 offset:20480
    s_branch L_k2_batch
L_k2_end:
    s_endpgm
.fill 64, 4, 0xBF800000
.section .rodata,"a"
.p2align 6
.amdhsa_kernel gather_scatter__cheap_equivariant_egnn__graph_kernel
  .amdhsa_next_free_vgpr 224
  .amdhsa_next_free_sgpr 102
  .amdhsa_accum_offset 224
  .amdhsa_group_segment_fixed_size 0
  .amdhsa_kernarg_size 88
  .amdhsa_user_sgpr_count 2
  .amdhsa_user_sgpr_kernarg_segment_ptr 1
  .amdhsa_system_sgpr_workgroup_id_x 1
  .amdhsa_float_denorm_mode_32 3
.end_amdhsa_kernel
```
